```python
import torch

def _softmax(x, axis=-1):
    return torch.softmax(x, dim=axis)
def _gelu(x):
    return torch.nn.functional.gelu(x, approximate="tanh")
def _silu(x):
    return torch.nn.functional.silu(x)
def _sigmoid(x):
    return torch.sigmoid(x)
def _layernorm(x, axis=-1, eps=1e-5):
    m = x.mean(dim=axis, keepdim=True)
    v = x.var(dim=axis, keepdim=True, unbiased=False)
    return (x - m) / torch.sqrt(v + eps)
def _scatter_add(tgt, idx, src, axis=0):
    return tgt.clone().index_add_(axis, idx, src)
def _segment_sum(src, seg, n):
    out = torch.zeros((n,) + src.shape[1:], dtype=src.dtype)
    return out.index_add_(0, seg, src)
def _pad(x, pw):
    flat = tuple(v for pair in reversed(pw) for v in pair)
    return torch.nn.functional.pad(x, flat)

kernel_name = 'standalone__groupnorm__prompt'

def setup_inputs():

    _w = (lambda a: (lambda t: t.to(torch.bfloat16) if t.is_floating_point() else t)(torch.as_tensor(a)))
    B = 1
    G = 32
    cpg = max(1, 448 // G)
    C = G * cpg
    H, W = 16, 4096
    return {
        "x": _w(abs((lambda *s: torch.randn(*s, dtype=torch.bfloat16) * 0.05)(B, C, H, W))),
        "g": _w((lambda *s: torch.randn(*s, dtype=torch.bfloat16) * 0.05)(C) + 1.0),
        "b": _w((lambda *s: torch.randn(*s, dtype=torch.bfloat16) * 0.4)(C)),
    }

def reference(x, g, b):
    G = 32
    B, C, H, W = x.shape[0], x.shape[1], x.shape[2], x.shape[3]
    xr = x.reshape(B, G, C // G, H, W)
    mu = xr.mean(axis=(2, 3, 4), keepdims=True)
    var = ((xr - mu) ** 2).mean(axis=(2, 3, 4), keepdims=True)
    xn = (xr - mu) / torch.sqrt(var + 1e-5)
    xn = xn.reshape(B, C, H, W)
    return xn * g[None, :, None, None] + b[None, :, None, None]
```

```asm
; @launch grid=(256,1,1) block=(1024,1,1) lds=256
.amdgcn_target "amdgcn-amd-amdhsa--gfx950"
.text
.globl standalone__groupnorm__prompt_kernel
.p2align 8
.type standalone__groupnorm__prompt_kernel,@function
standalone__groupnorm__prompt_kernel:
    s_load_dwordx2 s[16:17], s[0:1], 0
    s_load_dwordx8 s[4:11], s[0:1], 0
    s_load_dwordx2 s[14:15], s[0:1], 40
    v_lshrrev_b32 v6, 6, v0
    s_lshr_b32 s13, s2, 4
    s_cmp_ge_u32 s13, 16
    s_cbranch_scc1 L_end
    v_readfirstlane_b32 s27, v6
    v_and_b32 v1, 63, v0
    v_lshlrev_b32 v1, 4, v1
    s_mov_b32 s18, 58720256
    s_mov_b32 s19, 0x00020000
    s_cmp_eq_u32 s27, 0
    s_cbranch_scc1 L_helper
L_ids:
    s_lshr_b32 s12, s27, 3
    s_lshl1_add_u32 s3, s13, s12
    s_mul_i32 s40, s3, 1835008
    s_and_b32 s28, s2, 12
    s_lshl_b32 s28, s28, 11
    s_and_b32 s29, s2, 3
    s_lshl_b32 s29, s29, 15
    s_add_u32 s40, s40, s28
    s_add_u32 s40, s40, s29
    s_lshr_b32 s28, s2, 4
    s_lshl_b32 s28, s28, 2
    s_xor_b32 s28, s28, s27
    s_and_b32 s28, s28, 7
    s_lshl_b32 s28, s28, 10
    s_add_u32 s40, s40, s28
    s_setprio 2
    s_sub_u32 s28, s27, 1
    s_cmp_ge_u32 s28, 6
    s_cbranch_scc1 L_dyn
    s_and_b32 s28, s2, 4
    s_lshl_b32 s28, s28, 12
    s_sub_u32 s32, 0x22000, s28
    s_sub_u32 s33, 0x40000, s32
    s_waitcnt lgkmcnt(0)
    buffer_load_dwordx4 v[8:11], v1, s[16:19], s40 offen nt
    s_add_u32 s41, s40, s32
    buffer_load_dwordx4 v[12:15], v1, s[16:19], s41 offen nt
    s_add_u32 s42, s41, s33
    buffer_load_dwordx4 v[16:19], v1, s[16:19], s42 offen nt
    s_add_u32 s43, s42, s32
    buffer_load_dwordx4 v[20:23], v1, s[16:19], s43 offen nt
    s_add_u32 s44, s43, s33
    buffer_load_dwordx4 v[24:27], v1, s[16:19], s44 offen nt
    s_add_u32 s45, s44, s32
    buffer_load_dwordx4 v[28:31], v1, s[16:19], s45 offen nt
    s_add_u32 s46, s45, s33
    buffer_load_dwordx4 v[32:35], v1, s[16:19], s46 offen nt
    s_add_u32 s47, s46, s32
    buffer_load_dwordx4 v[36:39], v1, s[16:19], s47 offen nt
    s_add_u32 s48, s47, s33
    buffer_load_dwordx4 v[40:43], v1, s[16:19], s48 offen nt
    s_add_u32 s49, s48, s32
    buffer_load_dwordx4 v[44:47], v1, s[16:19], s49 offen nt
    s_add_u32 s50, s49, s33
    buffer_load_dwordx4 v[48:51], v1, s[16:19], s50 offen nt
    s_add_u32 s51, s50, s32
    buffer_load_dwordx4 v[52:55], v1, s[16:19], s51 offen nt
    s_add_u32 s52, s51, s33
    buffer_load_dwordx4 v[56:59], v1, s[16:19], s52 offen nt
    s_add_u32 s53, s52, s32
    buffer_load_dwordx4 v[60:63], v1, s[16:19], s53 offen nt
    s_barrier
    s_branch L_stats
L_helper:
    s_setprio 3
    v_mov_b32 v2, 0
    v_mov_b32 v3, 0
    v_mov_b32 v4, 0
    v_mov_b32 v5, 0
    v_mov_b32 v7, 0
    s_mov_b64 exec, 0xff
    ds_write_b128 v1, v[2:5]
    s_mov_b64 exec, -1
    s_lshr_b32 s40, s2, 1
    s_and_b32 s40, s40, 2
    s_xor_b32 s40, s40, s2
    s_and_b32 s40, s40, 7
    s_mul_i32 s43, s13, 3670016
    s_lshl_b32 s44, s2, 10
    s_and_b32 s44, s44, 0x2000
    s_xor_b32 s50, s44, 0x2000
    s_and_b32 s45, s13, 7
    s_lshl_b32 s45, s45, 14
    s_add_u32 s45, s45, 0x3fff
    s_lshl_b32 s36, s13, 10
    v_mov_b32 v8, s36
    s_cmp_ge_u32 s40, 3
    s_cselect_b32 s41, 3, 0
    s_sub_u32 s41, s40, s41
    s_cmp_ge_u32 s40, 3
    s_waitcnt lgkmcnt(0)
    s_cselect_b32 s56, s10, s4
    s_cselect_b32 s57, s11, s5
    global_load_dword v9, v8, s[14:15] sc1
    s_add_u32 s36, s36, 256
    s_cmp_ge_u32 s40, 6
    s_cbranch_scc1 L_warm
    s_and_b32 s42, s56, 0x1fffff
    s_add_u32 s43, s43, s42
    s_lshr_b32 s43, s43, 21
    s_add_u32 s43, s43, s41
    s_lshl_b32 s43, s43, 21
    s_sub_i32 s43, s43, s42
    s_max_i32 s43, s43, 0
    s_min_i32 s43, s43, 58556416
    s_add_u32 s43, s43, s45
    s_add_u32 s56, s56, s43
    s_addc_u32 s57, s57, 0
    s_and_b32 s56, s56, 0xffffc000
    s_memtime s[62:63]
    s_load_dword s60, s[56:57], s44 glc
    s_load_dword s61, s[56:57], s50 glc
    s_getreg_b32 s45, hwreg(HW_REG_XCC_ID)
    s_lshr_b32 s46, s40, 1
    s_lshl_b32 s46, s46, 8
    s_and_b32 s47, s40, 1
    s_lshl4_add_u32 s46, s47, s46
    s_and_b32 s47, s2, 8
    s_add_u32 s46, s46, s47
    s_add_u32 s46, s46, s36
    s_sub_u32 s47, s45, s2
    s_and_b32 s47, s47, 7
    s_and_b32 s45, s45, 4
    s_lshl1_add_u32 s47, s45, s47
    s_waitcnt lgkmcnt(1)
    s_memtime s[64:65]
    s_waitcnt lgkmcnt(0)
    s_memtime s[66:67]
    s_lshl_b32 s48, s64, 1
    s_sub_u32 s48, s48, s62
    s_add_u32 s48, s48, 0x10000
    s_waitcnt vmcnt(0) lgkmcnt(0)
    s_sub_u32 s48, s48, s66
    v_readfirstlane_b32 s31, v9
    s_add_u32 s31, s31, 0x9e3779b2
    s_or_b32 s31, s31, 1
    s_lshl4_add_u32 s48, s48, s47
    s_mov_b32 s49, s31
    s_atomic_swap_x2 s[48:49], s[14:15], s46
    s_branch L_tag0
L_warm:
    s_lshr_b32 s41, s2, 2
    s_and_b32 s41, s41, 2
    s_and_b32 s42, s2, 1
    s_or_b32 s41, s41, s42
    s_lshl_b32 s42, s13, 2
    s_add_u32 s42, s42, s41
    s_lshl_b32 s42, s42, 9
    s_add_u32 s42, s42, 16384
    s_min_u32 s41, s41, 2
    s_lshl_b32 s41, s41, 8
    s_add_u32 s41, s41, s36
    s_load_dword s62, s[14:15], s41 glc
    s_load_dword s60, s[14:15], s42 glc
    s_load_dword s61, s[14:15], s42 offset:256 glc
    s_waitcnt vmcnt(0)
    v_readfirstlane_b32 s31, v9
    s_add_u32 s31, s31, 0x9e3779b2
    s_or_b32 s31, s31, 1
L_tag0:
    v_mov_b32 v3, s31
    s_add_u32 s0, s14, s36
    s_addc_u32 s1, s15, 0
    s_mov_b32 s39, 0
L_tab:
    s_load_dwordx8 s[64:71], s[0:1], 0 glc
    s_load_dwordx8 s[72:79], s[0:1], 256 glc
    s_load_dwordx8 s[80:87], s[0:1], 512 glc
    s_add_u32 s39, s39, 1
    s_cmp_gt_u32 s39, 0x100000
    s_waitcnt lgkmcnt(0)
    s_cbranch_scc1 L_tab2
    s_cmp_lg_u32 s65, s31
    s_cbranch_scc1 L_tab
    s_cmp_lg_u32 s67, s31
    s_cbranch_scc1 L_tab
    s_cmp_lg_u32 s69, s31
    s_cbranch_scc1 L_tab
    s_cmp_lg_u32 s71, s31
    s_cbranch_scc1 L_tab
    s_cmp_lg_u32 s73, s31
    s_cbranch_scc1 L_tab
    s_cmp_lg_u32 s75, s31
    s_cbranch_scc1 L_tab
    s_cmp_lg_u32 s77, s31
    s_cbranch_scc1 L_tab
    s_cmp_lg_u32 s79, s31
    s_cbranch_scc1 L_tab
    s_cmp_lg_u32 s81, s31
    s_cbranch_scc1 L_tab
    s_cmp_lg_u32 s83, s31
    s_cbranch_scc1 L_tab
    s_cmp_lg_u32 s85, s31
    s_cbranch_scc1 L_tab
    s_cmp_lg_u32 s87, s31
    s_cbranch_scc1 L_tab
L_tab2:
    s_movk_i32 s37, 4800
    s_movk_i32 s38, -4800
    s_sub_i32 s65, s64, s66
    s_min_i32 s65, s65, s37
    s_max_i32 s65, s65, s38
    s_sub_i32 s35, 0, s65
    s_bitcmp1_b32 s64, 3
    s_cselect_b32 s65, s35, s65
    s_sub_i32 s69, s68, s70
    s_min_i32 s69, s69, s37
    s_max_i32 s69, s69, s38
    s_sub_i32 s35, 0, s69
    s_bitcmp1_b32 s68, 3
    s_cselect_b32 s69, s35, s69
    s_sub_i32 s73, s72, s74
    s_min_i32 s73, s73, s37
    s_max_i32 s73, s73, s38
    s_sub_i32 s35, 0, s73
    s_bitcmp1_b32 s72, 3
    s_cselect_b32 s73, s35, s73
    s_sub_i32 s77, s76, s78
    s_min_i32 s77, s77, s37
    s_max_i32 s77, s77, s38
    s_sub_i32 s35, 0, s77
    s_bitcmp1_b32 s76, 3
    s_cselect_b32 s77, s35, s77
    s_sub_i32 s81, s80, s82
    s_min_i32 s81, s81, s37
    s_max_i32 s81, s81, s38
    s_sub_i32 s35, 0, s81
    s_bitcmp1_b32 s80, 3
    s_cselect_b32 s81, s35, s81
    s_sub_i32 s85, s84, s86
    s_min_i32 s85, s85, s37
    s_max_i32 s85, s85, s38
    s_sub_i32 s35, 0, s85
    s_bitcmp1_b32 s84, 3
    s_cselect_b32 s85, s35, s85
    s_mov_b32 s34, 0
    s_lshl_b32 s35, s85, 1
    s_sub_i32 s35, s35, s81
    s_cmp_gt_i32 s35, 0
    s_addc_u32 s34, s34, s34
    s_lshl_b32 s35, s81, 1
    s_sub_i32 s35, s35, s77
    s_sub_i32 s35, s35, s85
    s_cmp_gt_i32 s35, 0
    s_addc_u32 s34, s34, s34
    s_lshl_b32 s35, s77, 1
    s_sub_i32 s35, s35, s81
    s_cmp_gt_i32 s35, 0
    s_addc_u32 s34, s34, s34
    s_lshl_b32 s35, s73, 1
    s_sub_i32 s35, s35, s69
    s_cmp_gt_i32 s35, 0
    s_addc_u32 s34, s34, s34
    s_lshl_b32 s35, s69, 1
    s_sub_i32 s35, s35, s65
    s_sub_i32 s35, s35, s73
    s_cmp_gt_i32 s35, 0
    s_addc_u32 s34, s34, s34
    s_lshl_b32 s35, s65, 1
    s_sub_i32 s35, s35, s69
    s_cmp_gt_i32 s35, 0
    s_addc_u32 s34, s34, s34
    s_add_u32 s64, s64, s2
    s_bitcmp1_b32 s64, 2
    s_cselect_b32 s35, 63, 0
    s_xor_b32 s34, s34, s35
    v_mov_b32 v2, s34
    ds_write_b64 v7, v[2:3] offset:48
    s_waitcnt lgkmcnt(0)
    s_barrier
    s_branch L_ids
L_dyn:
    s_waitcnt lgkmcnt(0)
    s_andn2_b32 s40, s40, 0x2000
    s_mul_i32 s35, s13, 3670016
    v_mov_b32 v7, 0
    s_and_b32 s28, s4, 0x1fffff
    s_add_u32 s29, s28, s35
    s_lshr_b32 s29, s29, 21
    s_add_u32 s28, s28, s40
    s_lshr_b32 s56, s28, 21
    s_sub_u32 s56, s56, s29
    s_bitcmp1_b32 s28, 13
    s_cselect_b32 s58, -1, 0
    s_and_b32 s28, s28, 0x1fffff
    s_sub_u32 s28, 0x21ffff, s28
    s_lshr_b32 s28, s28, 17
    s_bfm_b32 s57, s28, 0
    s_and_b32 s28, s10, 0x1fffff
    s_add_u32 s29, s28, s35
    s_lshr_b32 s29, s29, 21
    s_add_u32 s28, s28, s40
    s_lshr_b32 s59, s28, 21
    s_sub_u32 s59, s59, s29
    s_add_u32 s59, s59, 3
    s_bitcmp1_b32 s28, 13
    s_cselect_b32 s61, -1, 0
    s_and_b32 s28, s28, 0x1fffff
    s_sub_u32 s28, 0x21ffff, s28
    s_lshr_b32 s28, s28, 17
    s_bfm_b32 s60, s28, 0
    s_cmp_lg_u32 s27, 8
    s_cbranch_scc1 L_q8
    s_setprio 3
L_q8:
    s_cmp_lg_u32 s27, 12
    s_cbranch_scc1 L_q12
    s_setprio 1
L_q12:
    s_sub_u32 s28, s10, s4
    s_movk_i32 s62, 0x356a
    s_bitcmp1_b32 s28, 12
    s_cselect_b32 s62, 0x3f7e, s62
    s_movk_i32 s32, 0x2000
    s_mov_b32 s33, 0x20000
    s_mov_b32 s29, s40
    s_cmp_eq_u32 s27, 0
    s_cbranch_scc1 L_bm
    s_barrier
    ds_read_b32 v4, v7 offset:48
    s_waitcnt lgkmcnt(0)
    v_readfirstlane_b32 s34, v4
L_bm:
    s_lshr_b32 s35, s34, s56
    s_bitcmp1_b32 s35, 0
    s_cselect_b32 s28, s57, 0
    s_xor_b32 s58, s58, s28
    s_bitcmp1_b32 s35, 1
    s_cselect_b32 s28, -1, 0
    s_andn2_b32 s28, s28, s57
    s_xor_b32 s58, s58, s28
    s_lshr_b32 s35, s34, s59
    s_bitcmp1_b32 s35, 0
    s_cselect_b32 s28, s60, 0
    s_xor_b32 s61, s61, s28
    s_bitcmp1_b32 s35, 1
    s_cselect_b32 s28, -1, 0
    s_andn2_b32 s28, s28, s60
    s_xor_b32 s61, s61, s28
    s_andn2_b32 s58, s58, s62
    s_and_b32 s61, s61, s62
    s_or_b32 s58, s58, s61
    s_bitcmp1_b32 s58, 0
    s_cselect_b32 s28, s32, 0
    s_add_u32 s40, s29, s28
    buffer_load_dwordx4 v[8:11], v1, s[16:19], s40 offen nt
    s_add_u32 s29, s29, s33
    s_bitcmp1_b32 s58, 1
    s_cselect_b32 s28, s32, 0
    s_add_u32 s41, s29, s28
    buffer_load_dwordx4 v[12:15], v1, s[16:19], s41 offen nt
    s_add_u32 s29, s29, s33
    s_bitcmp1_b32 s58, 2
    s_cselect_b32 s28, s32, 0
    s_add_u32 s42, s29, s28
    buffer_load_dwordx4 v[16:19], v1, s[16:19], s42 offen nt
    s_cmp_lg_u32 s27, 8
    s_cbranch_scc1 L_r8
    s_setprio 1
L_r8:
    s_add_u32 s29, s29, s33
    s_bitcmp1_b32 s58, 3
    s_cselect_b32 s28, s32, 0
    s_add_u32 s43, s29, s28
    buffer_load_dwordx4 v[20:23], v1, s[16:19], s43 offen nt
    s_add_u32 s29, s29, s33
    s_bitcmp1_b32 s58, 4
    s_cselect_b32 s28, s32, 0
    s_add_u32 s44, s29, s28
    buffer_load_dwordx4 v[24:27], v1, s[16:19], s44 offen nt
    s_add_u32 s29, s29, s33
    s_bitcmp1_b32 s58, 5
    s_cselect_b32 s28, s32, 0
    s_add_u32 s45, s29, s28
    buffer_load_dwordx4 v[28:31], v1, s[16:19], s45 offen nt
    s_add_u32 s29, s29, s33
    s_bitcmp1_b32 s58, 6
    s_cselect_b32 s28, s32, 0
    s_add_u32 s46, s29, s28
    buffer_load_dwordx4 v[32:35], v1, s[16:19], s46 offen nt
    s_add_u32 s29, s29, s33
    s_bitcmp1_b32 s58, 7
    s_cselect_b32 s28, s32, 0
    s_add_u32 s47, s29, s28
    buffer_load_dwordx4 v[36:39], v1, s[16:19], s47 offen nt
    s_add_u32 s29, s29, s33
    s_bitcmp1_b32 s58, 8
    s_cselect_b32 s28, s32, 0
    s_add_u32 s48, s29, s28
    buffer_load_dwordx4 v[40:43], v1, s[16:19], s48 offen nt
    s_add_u32 s29, s29, s33
    s_bitcmp1_b32 s58, 9
    s_cselect_b32 s28, s32, 0
    s_add_u32 s49, s29, s28
    buffer_load_dwordx4 v[44:47], v1, s[16:19], s49 offen nt
    s_add_u32 s29, s29, s33
    s_bitcmp1_b32 s58, 10
    s_cselect_b32 s28, s32, 0
    s_add_u32 s50, s29, s28
    buffer_load_dwordx4 v[48:51], v1, s[16:19], s50 offen nt
    s_add_u32 s29, s29, s33
    s_bitcmp1_b32 s58, 11
    s_cselect_b32 s28, s32, 0
    s_add_u32 s51, s29, s28
    buffer_load_dwordx4 v[52:55], v1, s[16:19], s51 offen nt
    s_add_u32 s29, s29, s33
    s_bitcmp1_b32 s58, 12
    s_cselect_b32 s28, s32, 0
    s_add_u32 s52, s29, s28
    buffer_load_dwordx4 v[56:59], v1, s[16:19], s52 offen nt
    s_add_u32 s29, s29, s33
    s_bitcmp1_b32 s58, 13
    s_cselect_b32 s28, s32, 0
    s_add_u32 s53, s29, s28
    buffer_load_dwordx4 v[60:63], v1, s[16:19], s53 offen nt
L_stats:
    s_mul_i32 s28, s3, 1835008
    s_load_dwordx2 s[24:25], s[4:5], s28
    s_cmp_lg_u32 s27, 9
    s_cbranch_scc1 L_notlb
    s_lshr_b32 s28, s2, 3
    s_lshl_b32 s28, s28, 21
    s_min_u32 s28, s28, 58720192
    s_load_dword s29, s[10:11], s28 glc
L_notlb:
    s_mul_i32 s28, s3, 28
    s_add_u32 s6, s6, s28
    s_addc_u32 s7, s7, 0
    s_add_u32 s8, s8, s28
    s_addc_u32 s9, s9, 0
    s_load_dwordx4 s[56:59], s[6:7], 0
    s_load_dwordx2 s[60:61], s[6:7], 16
    s_load_dword s62, s[6:7], 24
    s_load_dwordx4 s[64:67], s[8:9], 0
    s_load_dwordx2 s[68:69], s[8:9], 16
    s_load_dword s70, s[8:9], 24
    s_mov_b32 s20, s10
    s_mov_b32 s21, s11
    s_mov_b32 s22, s18
    s_mov_b32 s23, 0x00020000
    s_mov_b32 s30, 0x3f803f80
    v_mov_b32 v2, 0
    v_mov_b32 v3, 0
    v_mov_b32 v4, 0
    v_mov_b32 v5, 0
    v_mov_b32 v7, 0
    s_lshl_b32 s38, s27, 3
    v_mov_b32 v6, s38
    s_lshl_b32 s38, s12, 2
    v_mov_b32 v73, s38
    v_lshlrev_b32 v75, 1, v73
    v_mov_b32 v74, 1
    s_mov_b32 s34, 0
    s_brev_b32 s35, 1
    v_writelane_b32 v76, s40, 0
    v_writelane_b32 v76, s41, 1
    v_writelane_b32 v76, s42, 2
    v_writelane_b32 v76, s43, 3
    v_writelane_b32 v76, s44, 4
    v_writelane_b32 v76, s45, 5
    v_writelane_b32 v76, s46, 6
    v_writelane_b32 v76, s47, 7
    v_writelane_b32 v76, s48, 8
    v_writelane_b32 v76, s49, 9
    v_writelane_b32 v76, s50, 10
    v_writelane_b32 v76, s51, 11
    v_writelane_b32 v76, s52, 12
    v_writelane_b32 v76, s53, 13
    s_waitcnt vmcnt(13)
    v_dot2c_f32_bf16 v2, s30, v8
    v_dot2c_f32_bf16 v3, v8, v8
    v_dot2c_f32_bf16 v4, s30, v9
    v_dot2c_f32_bf16 v5, v9, v9
    v_dot2c_f32_bf16 v2, s30, v10
    v_dot2c_f32_bf16 v3, v10, v10
    v_dot2c_f32_bf16 v4, s30, v11
    v_dot2c_f32_bf16 v5, v11, v11
    s_waitcnt vmcnt(12)
    v_dot2c_f32_bf16 v2, s30, v12
    v_dot2c_f32_bf16 v3, v12, v12
    v_dot2c_f32_bf16 v4, s30, v13
    v_dot2c_f32_bf16 v5, v13, v13
    v_dot2c_f32_bf16 v2, s30, v14
    v_dot2c_f32_bf16 v3, v14, v14
    v_dot2c_f32_bf16 v4, s30, v15
    v_dot2c_f32_bf16 v5, v15, v15
    s_waitcnt vmcnt(11)
    v_dot2c_f32_bf16 v2, s30, v16
    v_dot2c_f32_bf16 v3, v16, v16
    v_dot2c_f32_bf16 v4, s30, v17
    v_dot2c_f32_bf16 v5, v17, v17
    v_dot2c_f32_bf16 v2, s30, v18
    v_dot2c_f32_bf16 v3, v18, v18
    v_dot2c_f32_bf16 v4, s30, v19
    v_dot2c_f32_bf16 v5, v19, v19
    s_waitcnt vmcnt(10)
    v_dot2c_f32_bf16 v2, s30, v20
    v_dot2c_f32_bf16 v3, v20, v20
    v_dot2c_f32_bf16 v4, s30, v21
    v_dot2c_f32_bf16 v5, v21, v21
    v_dot2c_f32_bf16 v2, s30, v22
    v_dot2c_f32_bf16 v3, v22, v22
    v_dot2c_f32_bf16 v4, s30, v23
    v_dot2c_f32_bf16 v5, v23, v23
    s_waitcnt vmcnt(9)
    v_dot2c_f32_bf16 v2, s30, v24
    v_dot2c_f32_bf16 v3, v24, v24
    v_dot2c_f32_bf16 v4, s30, v25
    v_dot2c_f32_bf16 v5, v25, v25
    v_dot2c_f32_bf16 v2, s30, v26
    v_dot2c_f32_bf16 v3, v26, v26
    v_dot2c_f32_bf16 v4, s30, v27
    v_dot2c_f32_bf16 v5, v27, v27
    s_waitcnt vmcnt(8)
    v_dot2c_f32_bf16 v2, s30, v28
    v_dot2c_f32_bf16 v3, v28, v28
    v_dot2c_f32_bf16 v4, s30, v29
    v_dot2c_f32_bf16 v5, v29, v29
    v_dot2c_f32_bf16 v2, s30, v30
    v_dot2c_f32_bf16 v3, v30, v30
    v_dot2c_f32_bf16 v4, s30, v31
    v_dot2c_f32_bf16 v5, v31, v31
    s_waitcnt vmcnt(7)
    v_dot2c_f32_bf16 v2, s30, v32
    v_dot2c_f32_bf16 v3, v32, v32
    v_dot2c_f32_bf16 v4, s30, v33
    v_dot2c_f32_bf16 v5, v33, v33
    v_dot2c_f32_bf16 v2, s30, v34
    v_dot2c_f32_bf16 v3, v34, v34
    v_dot2c_f32_bf16 v4, s30, v35
    v_dot2c_f32_bf16 v5, v35, v35
    s_waitcnt vmcnt(6)
    v_dot2c_f32_bf16 v2, s30, v36
    v_dot2c_f32_bf16 v3, v36, v36
    v_dot2c_f32_bf16 v4, s30, v37
    v_dot2c_f32_bf16 v5, v37, v37
    v_dot2c_f32_bf16 v2, s30, v38
    v_dot2c_f32_bf16 v3, v38, v38
    v_dot2c_f32_bf16 v4, s30, v39
    v_dot2c_f32_bf16 v5, v39, v39
    s_waitcnt vmcnt(5)
    v_dot2c_f32_bf16 v2, s30, v40
    v_dot2c_f32_bf16 v3, v40, v40
    v_dot2c_f32_bf16 v4, s30, v41
    v_dot2c_f32_bf16 v5, v41, v41
    v_dot2c_f32_bf16 v2, s30, v42
    v_dot2c_f32_bf16 v3, v42, v42
    v_dot2c_f32_bf16 v4, s30, v43
    v_dot2c_f32_bf16 v5, v43, v43
    s_waitcnt vmcnt(4)
    v_dot2c_f32_bf16 v2, s30, v44
    v_dot2c_f32_bf16 v3, v44, v44
    v_dot2c_f32_bf16 v4, s30, v45
    v_dot2c_f32_bf16 v5, v45, v45
    v_dot2c_f32_bf16 v2, s30, v46
    v_dot2c_f32_bf16 v3, v46, v46
    v_dot2c_f32_bf16 v4, s30, v47
    v_dot2c_f32_bf16 v5, v47, v47
    s_waitcnt vmcnt(3)
    v_dot2c_f32_bf16 v2, s30, v48
    v_dot2c_f32_bf16 v3, v48, v48
    v_dot2c_f32_bf16 v4, s30, v49
    v_dot2c_f32_bf16 v5, v49, v49
    v_dot2c_f32_bf16 v2, s30, v50
    v_dot2c_f32_bf16 v3, v50, v50
    v_dot2c_f32_bf16 v4, s30, v51
    v_dot2c_f32_bf16 v5, v51, v51
    s_waitcnt vmcnt(2)
    v_dot2c_f32_bf16 v2, s30, v52
    v_dot2c_f32_bf16 v3, v52, v52
    v_dot2c_f32_bf16 v4, s30, v53
    v_dot2c_f32_bf16 v5, v53, v53
    v_dot2c_f32_bf16 v2, s30, v54
    v_dot2c_f32_bf16 v3, v54, v54
    v_dot2c_f32_bf16 v4, s30, v55
    v_dot2c_f32_bf16 v5, v55, v55
    s_waitcnt vmcnt(1)
    v_dot2c_f32_bf16 v2, s30, v56
    v_dot2c_f32_bf16 v3, v56, v56
    v_dot2c_f32_bf16 v4, s30, v57
    v_dot2c_f32_bf16 v5, v57, v57
    v_dot2c_f32_bf16 v2, s30, v58
    v_dot2c_f32_bf16 v3, v58, v58
    v_dot2c_f32_bf16 v4, s30, v59
    v_dot2c_f32_bf16 v5, v59, v59
    s_waitcnt lgkmcnt(0)
    s_lshl_b32 s26, s24, 16
    s_and_b32 s24, s24, 0xffff0000
    s_lshl_b32 s25, s25, 16
    v_mov_b32 v77, s26
    v_mov_b32 v78, s24
    v_med3_f32 v77, v77, v78, s25
    s_waitcnt vmcnt(0)
    v_dot2c_f32_bf16 v2, s30, v60
    v_dot2c_f32_bf16 v3, v60, v60
    v_dot2c_f32_bf16 v4, s30, v61
    v_dot2c_f32_bf16 v5, v61, v61
    v_dot2c_f32_bf16 v2, s30, v62
    v_dot2c_f32_bf16 v3, v62, v62
    v_dot2c_f32_bf16 v4, s30, v63
    v_dot2c_f32_bf16 v5, v63, v63
    s_nop 2
    v_add_f32 v2, v2, v4
    v_add_f32 v3, v3, v5
    v_fma_f32 v3, -v77, v2, v3
    v_fmac_f32 v2, 0xc2e00000, v77
    v_fma_f32 v3, -v77, v2, v3
    s_nop 1
    v_add_f32_dpp v2, v2, v2 row_shr:1 row_mask:0xf bank_mask:0xf bound_ctrl:0
    v_add_f32_dpp v3, v3, v3 row_shr:1 row_mask:0xf bank_mask:0xf bound_ctrl:0
    s_nop 0
    v_add_f32_dpp v2, v2, v2 row_shr:2 row_mask:0xf bank_mask:0xf bound_ctrl:0
    v_add_f32_dpp v3, v3, v3 row_shr:2 row_mask:0xf bank_mask:0xf bound_ctrl:0
    s_nop 0
    v_add_f32_dpp v2, v2, v2 row_shr:4 row_mask:0xf bank_mask:0xf bound_ctrl:0
    v_add_f32_dpp v3, v3, v3 row_shr:4 row_mask:0xf bank_mask:0xf bound_ctrl:0
    s_nop 0
    v_add_f32_dpp v2, v2, v2 row_shr:8 row_mask:0xf bank_mask:0xf bound_ctrl:0
    v_add_f32_dpp v3, v3, v3 row_shr:8 row_mask:0xf bank_mask:0xf bound_ctrl:0
    s_nop 0
    v_add_f32_dpp v2, v2, v2 row_bcast:15 row_mask:0xa bank_mask:0xf
    v_add_f32_dpp v3, v3, v3 row_bcast:15 row_mask:0xa bank_mask:0xf
    s_nop 0
    v_add_f32_dpp v2, v2, v2 row_bcast:31 row_mask:0xc bank_mask:0xf
    v_add_f32_dpp v3, v3, v3 row_bcast:31 row_mask:0xc bank_mask:0xf
    s_nop 0
    s_mov_b64 exec, s[34:35]
    ds_write_b64 v6, v[2:3] offset:128
    ds_add_rtn_u32 v4, v73, v74 offset:0
    s_waitcnt lgkmcnt(0)
    v_readfirstlane_b32 s36, v4
    s_mov_b64 exec, -1
    s_cmp_lg_u32 s36, 7
    s_cbranch_scc1 L_wait
    s_setprio 3
    v_and_b32 v6, 7, v0
    s_lshl_b32 s38, s12, 3
    v_add_lshl_u32 v6, v6, s38, 3
    s_lshl_b32 s28, s3, 10
    s_add_u32 s28, s28, 16384
    s_add_u32 s0, s14, s28
    s_addc_u32 s1, s15, 0
    s_and_b32 s28, s2, 12
    s_lshl_b32 s28, s28, 6
    s_and_b32 s29, s2, 3
    s_lshl4_add_u32 s28, s29, s28
    ds_read_b64 v[2:3], v6 offset:128
    ds_read_b32 v5, v7 offset:52
    s_waitcnt lgkmcnt(0)
    v_readfirstlane_b32 s31, v5
    v_add_f32_dpp v2, v2, v2 row_shr:1 row_mask:0xf bank_mask:0xf bound_ctrl:0
    v_add_f32_dpp v3, v3, v3 row_shr:1 row_mask:0xf bank_mask:0xf bound_ctrl:0
    s_nop 0
    v_add_f32_dpp v2, v2, v2 row_shr:2 row_mask:0xf bank_mask:0xf bound_ctrl:0
    v_add_f32_dpp v3, v3, v3 row_shr:2 row_mask:0xf bank_mask:0xf bound_ctrl:0
    s_nop 0
    v_add_f32_dpp v2, v2, v2 row_shr:4 row_mask:0xf bank_mask:0xf bound_ctrl:0
    v_add_f32_dpp v3, v3, v3 row_shr:4 row_mask:0xf bank_mask:0xf bound_ctrl:0
    s_nop 0
    s_mov_b32 s33, s31
    v_readlane_b32 s32, v2, 7
    v_readlane_b32 s34, v3, 7
    s_mov_b32 s35, s31
    s_mov_b32 s26, 0
    s_mov_b32 s29, 15
    s_nop 1
    s_atomic_swap_x2 s[32:33], s[0:1], s28
    s_atomic_swap_x2 s[34:35], s[0:1], s28 offset:8
L_poll:
    s_bitcmp0_b32 s29, 0
    s_cbranch_scc1 L_pl0
    s_load_dwordx16 s[36:51], s[0:1], 0x0 glc
L_pl0:
    s_bitcmp0_b32 s29, 1
    s_cbranch_scc1 L_pl1
    s_load_dwordx16 s[52:67], s[0:1], 0x100 glc
L_pl1:
    s_bitcmp0_b32 s29, 2
    s_cbranch_scc1 L_pl2
    s_load_dwordx16 s[68:83], s[0:1], 0x200 glc
L_pl2:
    s_bitcmp0_b32 s29, 3
    s_cbranch_scc1 L_pl3
    s_load_dwordx16 s[84:99], s[0:1], 0x300 glc
L_pl3:
    s_add_u32 s26, s26, 1
    s_cmp_gt_u32 s26, 0x100000
    s_cselect_b32 s29, 0, s29
    s_waitcnt lgkmcnt(0)
    s_bitcmp0_b32 s29, 0
    s_cbranch_scc1 L_pc0
    s_cmp_lg_u32 s37, s31
    s_cbranch_scc1 L_pc0
    s_cmp_lg_u32 s39, s31
    s_cbranch_scc1 L_pc0
    s_cmp_lg_u32 s41, s31
    s_cbranch_scc1 L_pc0
    s_cmp_lg_u32 s43, s31
    s_cbranch_scc1 L_pc0
    s_cmp_lg_u32 s45, s31
    s_cbranch_scc1 L_pc0
    s_cmp_lg_u32 s47, s31
    s_cbranch_scc1 L_pc0
    s_cmp_lg_u32 s49, s31
    s_cbranch_scc1 L_pc0
    s_cmp_lg_u32 s51, s31
    s_cbranch_scc1 L_pc0
    v_mov_b32 v64, s36
    v_mov_b32 v65, s38
    v_add_f32 v64, s40, v64
    v_add_f32 v65, s42, v65
    v_add_f32 v64, s44, v64
    v_add_f32 v65, s46, v65
    v_add_f32 v64, s48, v64
    v_add_f32 v65, s50, v65
    s_bitset0_b32 s29, 0
L_pc0:
    s_bitcmp0_b32 s29, 1
    s_cbranch_scc1 L_pc1
    s_cmp_lg_u32 s53, s31
    s_cbranch_scc1 L_pc1
    s_cmp_lg_u32 s55, s31
    s_cbranch_scc1 L_pc1
    s_cmp_lg_u32 s57, s31
    s_cbranch_scc1 L_pc1
    s_cmp_lg_u32 s59, s31
    s_cbranch_scc1 L_pc1
    s_cmp_lg_u32 s61, s31
    s_cbranch_scc1 L_pc1
    s_cmp_lg_u32 s63, s31
    s_cbranch_scc1 L_pc1
    s_cmp_lg_u32 s65, s31
    s_cbranch_scc1 L_pc1
    s_cmp_lg_u32 s67, s31
    s_cbranch_scc1 L_pc1
    v_mov_b32 v66, s52
    v_mov_b32 v67, s54
    v_add_f32 v66, s56, v66
    v_add_f32 v67, s58, v67
    v_add_f32 v66, s60, v66
    v_add_f32 v67, s62, v67
    v_add_f32 v66, s64, v66
    v_add_f32 v67, s66, v67
    s_bitset0_b32 s29, 1
L_pc1:
    s_bitcmp0_b32 s29, 2
    s_cbranch_scc1 L_pc2
    s_cmp_lg_u32 s69, s31
    s_cbranch_scc1 L_pc2
    s_cmp_lg_u32 s71, s31
    s_cbranch_scc1 L_pc2
    s_cmp_lg_u32 s73, s31
    s_cbranch_scc1 L_pc2
    s_cmp_lg_u32 s75, s31
    s_cbranch_scc1 L_pc2
    s_cmp_lg_u32 s77, s31
    s_cbranch_scc1 L_pc2
    s_cmp_lg_u32 s79, s31
    s_cbranch_scc1 L_pc2
    s_cmp_lg_u32 s81, s31
    s_cbranch_scc1 L_pc2
    s_cmp_lg_u32 s83, s31
    s_cbranch_scc1 L_pc2
    v_mov_b32 v68, s68
    v_mov_b32 v69, s70
    v_add_f32 v68, s72, v68
    v_add_f32 v69, s74, v69
    v_add_f32 v68, s76, v68
    v_add_f32 v69, s78, v69
    v_add_f32 v68, s80, v68
    v_add_f32 v69, s82, v69
    s_bitset0_b32 s29, 2
L_pc2:
    s_bitcmp0_b32 s29, 3
    s_cbranch_scc1 L_pc3
    s_cmp_lg_u32 s85, s31
    s_cbranch_scc1 L_pc3
    s_cmp_lg_u32 s87, s31
    s_cbranch_scc1 L_pc3
    s_cmp_lg_u32 s89, s31
    s_cbranch_scc1 L_pc3
    s_cmp_lg_u32 s91, s31
    s_cbranch_scc1 L_pc3
    s_cmp_lg_u32 s93, s31
    s_cbranch_scc1 L_pc3
    s_cmp_lg_u32 s95, s31
    s_cbranch_scc1 L_pc3
    s_cmp_lg_u32 s97, s31
    s_cbranch_scc1 L_pc3
    s_cmp_lg_u32 s99, s31
    s_cbranch_scc1 L_pc3
    v_mov_b32 v70, s84
    v_mov_b32 v71, s86
    v_add_f32 v70, s88, v70
    v_add_f32 v71, s90, v71
    v_add_f32 v70, s92, v70
    v_add_f32 v71, s94, v71
    v_add_f32 v70, s96, v70
    v_add_f32 v71, s98, v71
    s_bitset0_b32 s29, 3
L_pc3:
    s_cmp_lg_u32 s29, 0
    s_cbranch_scc1 L_poll
    s_load_dwordx4 s[56:59], s[6:7], 0
    s_load_dwordx2 s[60:61], s[6:7], 16
    s_load_dword s62, s[6:7], 24
    s_load_dwordx4 s[64:67], s[8:9], 0
    s_load_dwordx2 s[68:69], s[8:9], 16
    s_load_dword s70, s[8:9], 24
    v_add_f32 v2, v64, v66
    v_add_f32 v3, v65, v67
    v_add_f32 v4, v68, v70
    v_add_f32 v5, v69, v71
    v_add_f32 v2, v2, v4
    v_add_f32 v3, v3, v5
    v_mul_f32 v2, 0x35924925, v2
    v_mul_f32 v3, 0x35924925, v3
    v_fma_f32 v3, -v2, v2, v3
    v_max_f32 v3, 0, v3
    v_add_f32 v4, v2, v77
    v_cvt_pk_bf16_f32 v4, v4, v4
    v_and_b32 v4, 0xffff0000, v4
    v_sub_f32 v5, v77, v4
    v_add_f32 v5, v5, v2
    v_fma_f32 v3, v5, v5, v3
    v_cvt_pk_bf16_f32 v3, v3, v3
    v_and_b32 v3, 0xffff0000, v3
    v_add_f32 v3, 0x3727c5ac, v3
    v_cvt_pk_bf16_f32 v3, v3, v3
    v_and_b32 v3, 0xffff0000, v3
    v_sqrt_f32 v3, v3
    s_nop 0
    v_cvt_pk_bf16_f32 v3, v3, v3
    v_and_b32 v3, 0xffff0000, v3
    v_rcp_f32 v5, v3
    s_nop 0
    ds_write_b64 v75, v[4:5] offset:64
    ds_write_b32 v73, v74 offset:16
    v_readlane_b32 s40, v76, 0
    v_readlane_b32 s41, v76, 1
    v_readlane_b32 s42, v76, 2
    v_readlane_b32 s43, v76, 3
    v_readlane_b32 s44, v76, 4
    v_readlane_b32 s45, v76, 5
    v_readlane_b32 s46, v76, 6
    v_readlane_b32 s47, v76, 7
    v_readlane_b32 s48, v76, 8
    v_readlane_b32 s49, v76, 9
    v_readlane_b32 s50, v76, 10
    v_readlane_b32 s51, v76, 11
    v_readlane_b32 s52, v76, 12
    v_readlane_b32 s53, v76, 13
    s_and_b32 s28, s2, 15
    s_lshl1_add_u32 s28, s28, s12
    s_cmp_lg_u32 s28, 1
    s_cbranch_scc1 L_fin
    s_lshl_b32 s28, s13, 10
    v_mov_b32 v2, s28
    v_mov_b32 v3, s31
    s_mov_b64 exec, 1
    global_store_dword v2, v3, s[14:15] sc1
    s_mov_b64 exec, -1
L_fin:
    s_waitcnt lgkmcnt(0)
    s_branch L_norm
L_wait:
    ds_read_b32 v6, v73 offset:16
    ds_read_b64 v[4:5], v75 offset:64
    s_waitcnt lgkmcnt(0)
    v_readfirstlane_b32 s36, v6
    s_cmp_eq_u32 s36, 0
    s_cbranch_scc1 L_wait
L_norm:
    s_setprio 0
    s_mov_b32 s30, 0xffff0000
    s_lshl_b32 s34, s56, 16
    s_lshl_b32 s35, s64, 16
    v_mul_f32 v2, s34, v5
    v_fma_f32 v3, -v4, v2, s35
    v_lshlrev_b32 v64, 16, v8
    v_and_b32 v65, s30, v8
    v_lshlrev_b32 v66, 16, v9
    v_and_b32 v67, s30, v9
    v_lshlrev_b32 v68, 16, v10
    v_and_b32 v69, s30, v10
    v_lshlrev_b32 v70, 16, v11
    v_and_b32 v71, s30, v11
    v_pk_fma_f32 v[64:65], v[64:65], v[2:3], v[2:3] op_sel:[0,0,1] op_sel_hi:[1,0,1]
    v_pk_fma_f32 v[66:67], v[66:67], v[2:3], v[2:3] op_sel:[0,0,1] op_sel_hi:[1,0,1]
    v_pk_fma_f32 v[68:69], v[68:69], v[2:3], v[2:3] op_sel:[0,0,1] op_sel_hi:[1,0,1]
    v_pk_fma_f32 v[70:71], v[70:71], v[2:3], v[2:3] op_sel:[0,0,1] op_sel_hi:[1,0,1]
    v_cvt_pk_bf16_f32 v8, v64, v65
    v_cvt_pk_bf16_f32 v9, v66, v67
    v_cvt_pk_bf16_f32 v10, v68, v69
    v_cvt_pk_bf16_f32 v11, v70, v71
    buffer_store_dwordx4 v[8:11], v1, s[20:23], s40 offen sc1
    s_and_b32 s34, s56, s30
    s_and_b32 s35, s64, s30
    v_mul_f32 v2, s34, v5
    v_fma_f32 v3, -v4, v2, s35
    v_lshlrev_b32 v64, 16, v12
    v_and_b32 v65, s30, v12
    v_lshlrev_b32 v66, 16, v13
    v_and_b32 v67, s30, v13
    v_lshlrev_b32 v68, 16, v14
    v_and_b32 v69, s30, v14
    v_lshlrev_b32 v70, 16, v15
    v_and_b32 v71, s30, v15
    v_pk_fma_f32 v[64:65], v[64:65], v[2:3], v[2:3] op_sel:[0,0,1] op_sel_hi:[1,0,1]
    v_pk_fma_f32 v[66:67], v[66:67], v[2:3], v[2:3] op_sel:[0,0,1] op_sel_hi:[1,0,1]
    v_pk_fma_f32 v[68:69], v[68:69], v[2:3], v[2:3] op_sel:[0,0,1] op_sel_hi:[1,0,1]
    v_pk_fma_f32 v[70:71], v[70:71], v[2:3], v[2:3] op_sel:[0,0,1] op_sel_hi:[1,0,1]
    v_cvt_pk_bf16_f32 v12, v64, v65
    v_cvt_pk_bf16_f32 v13, v66, v67
    v_cvt_pk_bf16_f32 v14, v68, v69
    v_cvt_pk_bf16_f32 v15, v70, v71
    buffer_store_dwordx4 v[12:15], v1, s[20:23], s41 offen sc1
    s_lshl_b32 s34, s57, 16
    s_lshl_b32 s35, s65, 16
    v_mul_f32 v2, s34, v5
    v_fma_f32 v3, -v4, v2, s35
    v_lshlrev_b32 v64, 16, v16
    v_and_b32 v65, s30, v16
    v_lshlrev_b32 v66, 16, v17
    v_and_b32 v67, s30, v17
    v_lshlrev_b32 v68, 16, v18
    v_and_b32 v69, s30, v18
    v_lshlrev_b32 v70, 16, v19
    v_and_b32 v71, s30, v19
    v_pk_fma_f32 v[64:65], v[64:65], v[2:3], v[2:3] op_sel:[0,0,1] op_sel_hi:[1,0,1]
    v_pk_fma_f32 v[66:67], v[66:67], v[2:3], v[2:3] op_sel:[0,0,1] op_sel_hi:[1,0,1]
    v_pk_fma_f32 v[68:69], v[68:69], v[2:3], v[2:3] op_sel:[0,0,1] op_sel_hi:[1,0,1]
    v_pk_fma_f32 v[70:71], v[70:71], v[2:3], v[2:3] op_sel:[0,0,1] op_sel_hi:[1,0,1]
    v_cvt_pk_bf16_f32 v16, v64, v65
    v_cvt_pk_bf16_f32 v17, v66, v67
    v_cvt_pk_bf16_f32 v18, v68, v69
    v_cvt_pk_bf16_f32 v19, v70, v71
    buffer_store_dwordx4 v[16:19], v1, s[20:23], s42 offen sc1
    s_and_b32 s34, s57, s30
    s_and_b32 s35, s65, s30
    v_mul_f32 v2, s34, v5
    v_fma_f32 v3, -v4, v2, s35
    v_lshlrev_b32 v64, 16, v20
    v_and_b32 v65, s30, v20
    v_lshlrev_b32 v66, 16, v21
    v_and_b32 v67, s30, v21
    v_lshlrev_b32 v68, 16, v22
    v_and_b32 v69, s30, v22
    v_lshlrev_b32 v70, 16, v23
    v_and_b32 v71, s30, v23
    v_pk_fma_f32 v[64:65], v[64:65], v[2:3], v[2:3] op_sel:[0,0,1] op_sel_hi:[1,0,1]
    v_pk_fma_f32 v[66:67], v[66:67], v[2:3], v[2:3] op_sel:[0,0,1] op_sel_hi:[1,0,1]
    v_pk_fma_f32 v[68:69], v[68:69], v[2:3], v[2:3] op_sel:[0,0,1] op_sel_hi:[1,0,1]
    v_pk_fma_f32 v[70:71], v[70:71], v[2:3], v[2:3] op_sel:[0,0,1] op_sel_hi:[1,0,1]
    v_cvt_pk_bf16_f32 v20, v64, v65
    v_cvt_pk_bf16_f32 v21, v66, v67
    v_cvt_pk_bf16_f32 v22, v68, v69
    v_cvt_pk_bf16_f32 v23, v70, v71
    buffer_store_dwordx4 v[20:23], v1, s[20:23], s43 offen sc1
    s_lshl_b32 s34, s58, 16
    s_lshl_b32 s35, s66, 16
    v_mul_f32 v2, s34, v5
    v_fma_f32 v3, -v4, v2, s35
    v_lshlrev_b32 v64, 16, v24
    v_and_b32 v65, s30, v24
    v_lshlrev_b32 v66, 16, v25
    v_and_b32 v67, s30, v25
    v_lshlrev_b32 v68, 16, v26
    v_and_b32 v69, s30, v26
    v_lshlrev_b32 v70, 16, v27
    v_and_b32 v71, s30, v27
    v_pk_fma_f32 v[64:65], v[64:65], v[2:3], v[2:3] op_sel:[0,0,1] op_sel_hi:[1,0,1]
    v_pk_fma_f32 v[66:67], v[66:67], v[2:3], v[2:3] op_sel:[0,0,1] op_sel_hi:[1,0,1]
    v_pk_fma_f32 v[68:69], v[68:69], v[2:3], v[2:3] op_sel:[0,0,1] op_sel_hi:[1,0,1]
    v_pk_fma_f32 v[70:71], v[70:71], v[2:3], v[2:3] op_sel:[0,0,1] op_sel_hi:[1,0,1]
    v_cvt_pk_bf16_f32 v24, v64, v65
    v_cvt_pk_bf16_f32 v25, v66, v67
    v_cvt_pk_bf16_f32 v26, v68, v69
    v_cvt_pk_bf16_f32 v27, v70, v71
    buffer_store_dwordx4 v[24:27], v1, s[20:23], s44 offen sc1
    s_and_b32 s34, s58, s30
    s_and_b32 s35, s66, s30
    v_mul_f32 v2, s34, v5
    v_fma_f32 v3, -v4, v2, s35
    v_lshlrev_b32 v64, 16, v28
    v_and_b32 v65, s30, v28
    v_lshlrev_b32 v66, 16, v29
    v_and_b32 v67, s30, v29
    v_lshlrev_b32 v68, 16, v30
    v_and_b32 v69, s30, v30
    v_lshlrev_b32 v70, 16, v31
    v_and_b32 v71, s30, v31
    v_pk_fma_f32 v[64:65], v[64:65], v[2:3], v[2:3] op_sel:[0,0,1] op_sel_hi:[1,0,1]
    v_pk_fma_f32 v[66:67], v[66:67], v[2:3], v[2:3] op_sel:[0,0,1] op_sel_hi:[1,0,1]
    v_pk_fma_f32 v[68:69], v[68:69], v[2:3], v[2:3] op_sel:[0,0,1] op_sel_hi:[1,0,1]
    v_pk_fma_f32 v[70:71], v[70:71], v[2:3], v[2:3] op_sel:[0,0,1] op_sel_hi:[1,0,1]
    v_cvt_pk_bf16_f32 v28, v64, v65
    v_cvt_pk_bf16_f32 v29, v66, v67
    v_cvt_pk_bf16_f32 v30, v68, v69
    v_cvt_pk_bf16_f32 v31, v70, v71
    buffer_store_dwordx4 v[28:31], v1, s[20:23], s45 offen sc1
    s_lshl_b32 s34, s59, 16
    s_lshl_b32 s35, s67, 16
    v_mul_f32 v2, s34, v5
    v_fma_f32 v3, -v4, v2, s35
    v_lshlrev_b32 v64, 16, v32
    v_and_b32 v65, s30, v32
    v_lshlrev_b32 v66, 16, v33
    v_and_b32 v67, s30, v33
    v_lshlrev_b32 v68, 16, v34
    v_and_b32 v69, s30, v34
    v_lshlrev_b32 v70, 16, v35
    v_and_b32 v71, s30, v35
    v_pk_fma_f32 v[64:65], v[64:65], v[2:3], v[2:3] op_sel:[0,0,1] op_sel_hi:[1,0,1]
    v_pk_fma_f32 v[66:67], v[66:67], v[2:3], v[2:3] op_sel:[0,0,1] op_sel_hi:[1,0,1]
    v_pk_fma_f32 v[68:69], v[68:69], v[2:3], v[2:3] op_sel:[0,0,1] op_sel_hi:[1,0,1]
    v_pk_fma_f32 v[70:71], v[70:71], v[2:3], v[2:3] op_sel:[0,0,1] op_sel_hi:[1,0,1]
    v_cvt_pk_bf16_f32 v32, v64, v65
    v_cvt_pk_bf16_f32 v33, v66, v67
    v_cvt_pk_bf16_f32 v34, v68, v69
    v_cvt_pk_bf16_f32 v35, v70, v71
    buffer_store_dwordx4 v[32:35], v1, s[20:23], s46 offen sc1
    s_and_b32 s34, s59, s30
    s_and_b32 s35, s67, s30
    v_mul_f32 v2, s34, v5
    v_fma_f32 v3, -v4, v2, s35
    v_lshlrev_b32 v64, 16, v36
    v_and_b32 v65, s30, v36
    v_lshlrev_b32 v66, 16, v37
    v_and_b32 v67, s30, v37
    v_lshlrev_b32 v68, 16, v38
    v_and_b32 v69, s30, v38
    v_lshlrev_b32 v70, 16, v39
    v_and_b32 v71, s30, v39
    v_pk_fma_f32 v[64:65], v[64:65], v[2:3], v[2:3] op_sel:[0,0,1] op_sel_hi:[1,0,1]
    v_pk_fma_f32 v[66:67], v[66:67], v[2:3], v[2:3] op_sel:[0,0,1] op_sel_hi:[1,0,1]
    v_pk_fma_f32 v[68:69], v[68:69], v[2:3], v[2:3] op_sel:[0,0,1] op_sel_hi:[1,0,1]
    v_pk_fma_f32 v[70:71], v[70:71], v[2:3], v[2:3] op_sel:[0,0,1] op_sel_hi:[1,0,1]
    v_cvt_pk_bf16_f32 v36, v64, v65
    v_cvt_pk_bf16_f32 v37, v66, v67
    v_cvt_pk_bf16_f32 v38, v68, v69
    v_cvt_pk_bf16_f32 v39, v70, v71
    buffer_store_dwordx4 v[36:39], v1, s[20:23], s47 offen sc1
    s_lshl_b32 s34, s60, 16
    s_lshl_b32 s35, s68, 16
    v_mul_f32 v2, s34, v5
    v_fma_f32 v3, -v4, v2, s35
    v_lshlrev_b32 v64, 16, v40
    v_and_b32 v65, s30, v40
    v_lshlrev_b32 v66, 16, v41
    v_and_b32 v67, s30, v41
    v_lshlrev_b32 v68, 16, v42
    v_and_b32 v69, s30, v42
    v_lshlrev_b32 v70, 16, v43
    v_and_b32 v71, s30, v43
    v_pk_fma_f32 v[64:65], v[64:65], v[2:3], v[2:3] op_sel:[0,0,1] op_sel_hi:[1,0,1]
    v_pk_fma_f32 v[66:67], v[66:67], v[2:3], v[2:3] op_sel:[0,0,1] op_sel_hi:[1,0,1]
    v_pk_fma_f32 v[68:69], v[68:69], v[2:3], v[2:3] op_sel:[0,0,1] op_sel_hi:[1,0,1]
    v_pk_fma_f32 v[70:71], v[70:71], v[2:3], v[2:3] op_sel:[0,0,1] op_sel_hi:[1,0,1]
    v_cvt_pk_bf16_f32 v40, v64, v65
    v_cvt_pk_bf16_f32 v41, v66, v67
    v_cvt_pk_bf16_f32 v42, v68, v69
    v_cvt_pk_bf16_f32 v43, v70, v71
    buffer_store_dwordx4 v[40:43], v1, s[20:23], s48 offen sc1
    s_and_b32 s34, s60, s30
    s_and_b32 s35, s68, s30
    v_mul_f32 v2, s34, v5
    v_fma_f32 v3, -v4, v2, s35
    v_lshlrev_b32 v64, 16, v44
    v_and_b32 v65, s30, v44
    v_lshlrev_b32 v66, 16, v45
    v_and_b32 v67, s30, v45
    v_lshlrev_b32 v68, 16, v46
    v_and_b32 v69, s30, v46
    v_lshlrev_b32 v70, 16, v47
    v_and_b32 v71, s30, v47
    v_pk_fma_f32 v[64:65], v[64:65], v[2:3], v[2:3] op_sel:[0,0,1] op_sel_hi:[1,0,1]
    v_pk_fma_f32 v[66:67], v[66:67], v[2:3], v[2:3] op_sel:[0,0,1] op_sel_hi:[1,0,1]
    v_pk_fma_f32 v[68:69], v[68:69], v[2:3], v[2:3] op_sel:[0,0,1] op_sel_hi:[1,0,1]
    v_pk_fma_f32 v[70:71], v[70:71], v[2:3], v[2:3] op_sel:[0,0,1] op_sel_hi:[1,0,1]
    v_cvt_pk_bf16_f32 v44, v64, v65
    v_cvt_pk_bf16_f32 v45, v66, v67
    v_cvt_pk_bf16_f32 v46, v68, v69
    v_cvt_pk_bf16_f32 v47, v70, v71
    buffer_store_dwordx4 v[44:47], v1, s[20:23], s49 offen sc1
    s_lshl_b32 s34, s61, 16
    s_lshl_b32 s35, s69, 16
    v_mul_f32 v2, s34, v5
    v_fma_f32 v3, -v4, v2, s35
    v_lshlrev_b32 v64, 16, v48
    v_and_b32 v65, s30, v48
    v_lshlrev_b32 v66, 16, v49
    v_and_b32 v67, s30, v49
    v_lshlrev_b32 v68, 16, v50
    v_and_b32 v69, s30, v50
    v_lshlrev_b32 v70, 16, v51
    v_and_b32 v71, s30, v51
    v_pk_fma_f32 v[64:65], v[64:65], v[2:3], v[2:3] op_sel:[0,0,1] op_sel_hi:[1,0,1]
    v_pk_fma_f32 v[66:67], v[66:67], v[2:3], v[2:3] op_sel:[0,0,1] op_sel_hi:[1,0,1]
    v_pk_fma_f32 v[68:69], v[68:69], v[2:3], v[2:3] op_sel:[0,0,1] op_sel_hi:[1,0,1]
    v_pk_fma_f32 v[70:71], v[70:71], v[2:3], v[2:3] op_sel:[0,0,1] op_sel_hi:[1,0,1]
    v_cvt_pk_bf16_f32 v48, v64, v65
    v_cvt_pk_bf16_f32 v49, v66, v67
    v_cvt_pk_bf16_f32 v50, v68, v69
    v_cvt_pk_bf16_f32 v51, v70, v71
    buffer_store_dwordx4 v[48:51], v1, s[20:23], s50 offen sc1
    s_and_b32 s34, s61, s30
    s_and_b32 s35, s69, s30
    v_mul_f32 v2, s34, v5
    v_fma_f32 v3, -v4, v2, s35
    v_lshlrev_b32 v64, 16, v52
    v_and_b32 v65, s30, v52
    v_lshlrev_b32 v66, 16, v53
    v_and_b32 v67, s30, v53
    v_lshlrev_b32 v68, 16, v54
    v_and_b32 v69, s30, v54
    v_lshlrev_b32 v70, 16, v55
    v_and_b32 v71, s30, v55
    v_pk_fma_f32 v[64:65], v[64:65], v[2:3], v[2:3] op_sel:[0,0,1] op_sel_hi:[1,0,1]
    v_pk_fma_f32 v[66:67], v[66:67], v[2:3], v[2:3] op_sel:[0,0,1] op_sel_hi:[1,0,1]
    v_pk_fma_f32 v[68:69], v[68:69], v[2:3], v[2:3] op_sel:[0,0,1] op_sel_hi:[1,0,1]
    v_pk_fma_f32 v[70:71], v[70:71], v[2:3], v[2:3] op_sel:[0,0,1] op_sel_hi:[1,0,1]
    v_cvt_pk_bf16_f32 v52, v64, v65
    v_cvt_pk_bf16_f32 v53, v66, v67
    v_cvt_pk_bf16_f32 v54, v68, v69
    v_cvt_pk_bf16_f32 v55, v70, v71
    buffer_store_dwordx4 v[52:55], v1, s[20:23], s51 offen sc1
    s_lshl_b32 s34, s62, 16
    s_lshl_b32 s35, s70, 16
    v_mul_f32 v2, s34, v5
    v_fma_f32 v3, -v4, v2, s35
    v_lshlrev_b32 v64, 16, v56
    v_and_b32 v65, s30, v56
    v_lshlrev_b32 v66, 16, v57
    v_and_b32 v67, s30, v57
    v_lshlrev_b32 v68, 16, v58
    v_and_b32 v69, s30, v58
    v_lshlrev_b32 v70, 16, v59
    v_and_b32 v71, s30, v59
    v_pk_fma_f32 v[64:65], v[64:65], v[2:3], v[2:3] op_sel:[0,0,1] op_sel_hi:[1,0,1]
    v_pk_fma_f32 v[66:67], v[66:67], v[2:3], v[2:3] op_sel:[0,0,1] op_sel_hi:[1,0,1]
    v_pk_fma_f32 v[68:69], v[68:69], v[2:3], v[2:3] op_sel:[0,0,1] op_sel_hi:[1,0,1]
    v_pk_fma_f32 v[70:71], v[70:71], v[2:3], v[2:3] op_sel:[0,0,1] op_sel_hi:[1,0,1]
    v_cvt_pk_bf16_f32 v56, v64, v65
    v_cvt_pk_bf16_f32 v57, v66, v67
    v_cvt_pk_bf16_f32 v58, v68, v69
    v_cvt_pk_bf16_f32 v59, v70, v71
    buffer_store_dwordx4 v[56:59], v1, s[20:23], s52 offen sc1
    s_and_b32 s34, s62, s30
    s_and_b32 s35, s70, s30
    v_mul_f32 v2, s34, v5
    v_fma_f32 v3, -v4, v2, s35
    v_lshlrev_b32 v64, 16, v60
    v_and_b32 v65, s30, v60
    v_lshlrev_b32 v66, 16, v61
    v_and_b32 v67, s30, v61
    v_lshlrev_b32 v68, 16, v62
    v_and_b32 v69, s30, v62
    v_lshlrev_b32 v70, 16, v63
    v_and_b32 v71, s30, v63
    v_pk_fma_f32 v[64:65], v[64:65], v[2:3], v[2:3] op_sel:[0,0,1] op_sel_hi:[1,0,1]
    v_pk_fma_f32 v[66:67], v[66:67], v[2:3], v[2:3] op_sel:[0,0,1] op_sel_hi:[1,0,1]
    v_pk_fma_f32 v[68:69], v[68:69], v[2:3], v[2:3] op_sel:[0,0,1] op_sel_hi:[1,0,1]
    v_pk_fma_f32 v[70:71], v[70:71], v[2:3], v[2:3] op_sel:[0,0,1] op_sel_hi:[1,0,1]
    v_cvt_pk_bf16_f32 v60, v64, v65
    v_cvt_pk_bf16_f32 v61, v66, v67
    v_cvt_pk_bf16_f32 v62, v68, v69
    v_cvt_pk_bf16_f32 v63, v70, v71
    buffer_store_dwordx4 v[60:63], v1, s[20:23], s53 offen sc1
L_end:
    s_endpgm
.section .rodata,"a"
.p2align 6
.amdhsa_kernel standalone__groupnorm__prompt_kernel
  .amdhsa_next_free_vgpr 80
  .amdhsa_next_free_sgpr 100
  .amdhsa_accum_offset 80
  .amdhsa_group_segment_fixed_size 0
  .amdhsa_kernarg_size 48
  .amdhsa_user_sgpr_count 2
  .amdhsa_user_sgpr_kernarg_segment_ptr 1
  .amdhsa_system_sgpr_workgroup_id_x 1
  .amdhsa_float_denorm_mode_32 3
.end_amdhsa_kernel
```
